```python
import torch

def _softmax(x, axis=-1):
    return torch.softmax(x, dim=axis)

def _gelu(x):
    return torch.nn.functional.gelu(x, approximate='tanh')

def _silu(x):
    return torch.nn.functional.silu(x)

def _sigmoid(x):
    return torch.sigmoid(x)

def _layernorm(x, axis=-1, eps=1e-05):
    m = x.mean(dim=axis, keepdim=True)
    v = x.var(dim=axis, keepdim=True, unbiased=False)
    return (x - m) / torch.sqrt(v + eps)

def _scatter_add(tgt, idx, src, axis=0):
    return tgt.clone().index_add_(axis, idx, src)

def _segment_sum(src, seg, n):
    out = torch.zeros((n,) + src.shape[1:], dtype=src.dtype)
    return out.index_add_(0, seg, src)

def _pad(x, pw):
    flat = tuple((v for pair in reversed(pw) for v in pair))
    return torch.nn.functional.pad(x, flat)
kernel_name = 'standalone__tree_speculative_verify_tree_attention_over_candidate_token_tree__decode'

def setup_inputs():

    _w = lambda a: (lambda t: t.to(torch.bfloat16) if t.is_floating_point() else t)(torch.as_tensor(a))
    B, Hq, Hkv, T, C, D = (2, 32, 8, 1, 8192, 128)
    tree_mask = torch.zeros((B, T, T), dtype=float)
    for b in range(B):
        parent = torch.zeros(T, dtype=torch.int64)
        for i in range(1, T):
            parent[i] = int(torch.randint(0, i, (1,)).item())
        for i in range(T):
            j = i
            tree_mask[b, i, j] = 1.0
            while j > 0:
                j = parent[j]
                tree_mask[b, i, j] = 1.0
    return {'q': _w((lambda *s: torch.randn(*s, dtype=torch.bfloat16) * 0.8)(B, Hq, T, D)), 'k_cache': _w((lambda *s: torch.randn(*s, dtype=torch.bfloat16) * 0.8)(B, Hkv, C, D)), 'v_cache': _w((lambda *s: torch.randn(*s, dtype=torch.bfloat16) * 0.05)(B, Hkv, C, D)), 'k_tree': _w((lambda *s: torch.randn(*s, dtype=torch.bfloat16) * 0.8)(B, Hkv, T, D)), 'v_tree': _w((lambda *s: torch.randn(*s, dtype=torch.bfloat16) * 0.05)(B, Hkv, T, D)), 'tree_mask': _w(tree_mask)}

def reference(q, k_cache, v_cache, k_tree, v_tree, tree_mask):
    B, Hq, T, D = q.shape
    Hkv, C = (k_cache.shape[1], k_cache.shape[2])
    rep = Hq // Hkv
    kc = (lambda x, n, axis: torch.repeat_interleave(x, n, dim=axis))(k_cache, rep, axis=1)
    vc = (lambda x, n, axis: torch.repeat_interleave(x, n, dim=axis))(v_cache, rep, axis=1)
    kt = (lambda x, n, axis: torch.repeat_interleave(x, n, dim=axis))(k_tree, rep, axis=1)
    vt = (lambda x, n, axis: torch.repeat_interleave(x, n, dim=axis))(v_tree, rep, axis=1)
    k = torch.concatenate([kc, kt], axis=2)
    v = torch.concatenate([vc, vt], axis=2)
    scale = D ** (-0.5)
    scores = torch.einsum('bhqd,bhkd->bhqk', q, k) * scale
    ctx_mask = torch.ones((B, 1, T, C), dtype=scores.dtype)
    tm = tree_mask[:, None, :, :].clone()
    full_mask = torch.concatenate([ctx_mask, tm], axis=-1)
    scores = scores + (1.0 - full_mask) * -1000000000.0
    p = _softmax(scores, axis=-1)
    return torch.einsum('bhqk,bhkd->bhqd', p, v)
```

```asm
; @launch grid=(256,1,1) block=(256,1,1) lds=8320
.amdgcn_target "amdgcn-amd-amdhsa--gfx950"
.text
.globl standalone__tree_speculative_verify_tree_attention_over_candidate_token_tree__decode_kernel
.p2align 8
.type standalone__tree_speculative_verify_tree_attention_over_candidate_token_tree__decode_kernel,@function
standalone__tree_speculative_verify_tree_attention_over_candidate_token_tree__decode_kernel:
    s_cmp_ge_u32 s2, 256
    s_cbranch_scc1 L_end
    s_load_dwordx16 s[16:31], s[0:1], 0
    s_getpc_b64 s[14:15]
L_pc:
    v_and_b32 v39, 63, v0
    v_lshlrev_b32 v39, 7, v39
    v_min_u32 v39, L_code_end-L_pc-4, v39
    global_load_dword v37, v39, s[14:15]
    s_and_b32 s3, s2, 7
    s_lshr_b32 s2, s2, 3
    s_lshl_b32 s3, s3, 5
    s_add_u32 s2, s2, s3
    v_and_b32 v20, 63, v0
    v_lshrrev_b32 v21, 6, v0
    v_bfe_u32 v22, v0, 2, 2
    v_bfe_u32 v23, v0, 4, 2
    v_and_b32 v24, 3, v0
    v_readfirstlane_b32 s48, v21
    v_lshlrev_b32 v25, 12, v21
    v_lshl_add_u32 v2, v20, 4, v25
    v_lshlrev_b32 v26, 6, v23
    v_lshl_add_u32 v27, v24, 4, v26
    v_lshl_add_u32 v1, v22, 8, v27
    v_add_u32 v1, v1, v25
    v_lshl_add_u32 v3, v24, 8, v26
    v_lshl_add_u32 v3, v22, 4, v3
    s_lshl_b32 s3, s2, 17
    s_lshr_b32 s34, s2, 4
    s_and_b32 s35, s2, 15
    s_mov_b32 s10, 0x20000
    s_mov_b32 s11, 0x20000
    s_movk_i32 s6, 1024
    s_mov_b32 s7, 0x20000
    s_lshl_b32 s49, s34, 10
    s_or_b32 s50, s35, s48
    s_mov_b32 s37, 16384
    s_mov_b32 s38, 32768
    s_mov_b32 s39, 49152
    s_mov_b32 s40, 65536
    s_mov_b32 s41, 81920
    s_mov_b32 s42, 98304
    s_mov_b32 s43, 114688
    s_waitcnt lgkmcnt(0)
    s_add_u32 s4, s16, s49
    s_addc_u32 s5, s17, 0
    s_add_u32 s8, s18, s3
    s_addc_u32 s9, s19, 0
    buffer_load_dwordx4 v[8:11], v3, s[4:7], 0 offen
    s_load_dwordx2 s[32:33], s[0:1], 64
    buffer_load_dwordx4 v[104:107], v1, s[8:11], 0 offen offset:0 nt
    s_add_u32 s12, s20, s3
    s_addc_u32 s13, s21, 0
    buffer_load_dwordx4 v[108:111], v1, s[8:11], 0 offen offset:1024 nt
    s_mov_b32 s14, 0x20000
    s_mov_b32 s15, 0x20000
    buffer_load_dwordx4 v[112:115], v1, s[8:11], 0 offen offset:2048 nt
    s_add_u32 s65, s34, 2
    s_and_b32 s65, s65, 15
    buffer_load_dwordx4 v[116:119], v1, s[8:11], 0 offen offset:3072 nt
    s_lshl_b32 s47, s65, 10
    s_add_u32 s44, s28, s47
    buffer_load_dwordx4 v[120:123], v1, s[8:11], s37 offen offset:0 nt
    s_addc_u32 s45, s29, 0
    s_movk_i32 s46, 1024
    buffer_load_dwordx4 v[124:127], v1, s[8:11], s37 offen offset:1024 nt
    s_mov_b32 s47, 0x20000
    s_lshl_b32 s53, s65, 6
    buffer_load_dwordx4 v[128:131], v1, s[8:11], s37 offen offset:2048 nt
    s_lshl_b32 s54, s35, 2
    s_add_u32 s53, s53, s54
    buffer_load_dwordx4 v[132:135], v1, s[8:11], s37 offen offset:3072 nt
    s_add_u32 s53, s53, 0x100000
    s_lshl_b32 s64, s34, 6
    s_and_b32 s54, s48, 3
    s_lshl_b32 s54, s54, 4
    s_add_u32 s64, s64, s54
    s_add_u32 s64, s64, 0x100000
    v_and_b32 v4, 1, v22
    v_lshlrev_b32 v4, 4, v4
    v_mov_b32 v5, 0xffff
    v_lshlrev_b32 v4, v4, v5
    v_cmp_le_u32 vcc, 2, v22
    s_mov_b32 s49, 0x3e0293ee
    v_mov_b32 v36, 0xf149f2ca
    v_cndmask_b32 v5, 0, v4, vcc
    v_xor_b32 v4, v4, v5
    s_mov_b32 s62, 0x100800
    s_mov_b32 s63, 0x20000
    s_movk_i32 s58, 256
    s_cmp_lg_u32 s50, 0
    s_cbranch_scc1 L_notree_ld
    s_lshl_b32 s51, s34, 8
    s_add_u32 s56, s22, s51
    s_addc_u32 s57, s23, 0
    s_mov_b32 s59, 0x20000
    v_and_b32 v28, 15, v0
    v_lshlrev_b32 v28, 4, v28
    v_lshl_add_u32 v28, v23, 1, v28
    buffer_load_dwordx4 v[12:15], v27, s[56:59], 0 offen
    s_add_u32 s56, s24, s51
    s_addc_u32 s57, s25, 0
    buffer_load_ushort v16, v28, s[56:59], 0 offen
    buffer_load_ushort v17, v28, s[56:59], 0 offen offset:8
    s_load_dword s52, s[26:27], 0
L_notree_ld:
    s_waitcnt lgkmcnt(0)
    s_load_dwordx4 s[92:95], s[32:33], s64
    s_load_dword s55, s[32:33], s53
    s_mov_b32 s60, s32
    s_mov_b32 s61, s33
    s_waitcnt vmcnt(7)
    v_mfma_f32_16x16x32_bf16 v[20:23], v[104:107], v[8:11], 0
    buffer_load_dwordx4 v[104:107], v1, s[8:11], s38 offen offset:0 nt
    s_waitcnt vmcnt(7)
    v_mfma_f32_16x16x32_bf16 v[24:27], v[108:111], v[8:11], 0
    buffer_load_dwordx4 v[108:111], v1, s[8:11], s38 offen offset:1024 nt
    s_nop 3
    v_mov_b32_dpp v20, v21 quad_perm:[0,1,2,3] row_mask:0xf bank_mask:0x2
    v_mov_b32_dpp v20, v22 quad_perm:[0,1,2,3] row_mask:0xf bank_mask:0x4
    v_mov_b32_dpp v20, v23 quad_perm:[0,1,2,3] row_mask:0xf bank_mask:0x8
    s_waitcnt vmcnt(7)
    v_mfma_f32_16x16x32_bf16 v[28:31], v[112:115], v[8:11], 0
    buffer_load_dwordx4 v[112:115], v1, s[8:11], s38 offen offset:2048 nt
    v_add_f32_dpp v21, v20, v20 row_ror:8 row_mask:0xf bank_mask:0xf
    v_mov_b32_dpp v24, v25 quad_perm:[0,1,2,3] row_mask:0xf bank_mask:0x2
    v_mov_b32_dpp v24, v26 quad_perm:[0,1,2,3] row_mask:0xf bank_mask:0x4
    v_mov_b32_dpp v24, v27 quad_perm:[0,1,2,3] row_mask:0xf bank_mask:0x8
    s_waitcnt vmcnt(7)
    v_mfma_f32_16x16x32_bf16 v[32:35], v[116:119], v[8:11], 0
    buffer_load_dwordx4 v[116:119], v1, s[8:11], s38 offen offset:3072 nt
    v_add_f32_dpp v40, v21, v21 row_ror:4 row_mask:0xf bank_mask:0xf
    v_add_f32_dpp v25, v24, v24 row_ror:8 row_mask:0xf bank_mask:0xf
    v_mov_b32_dpp v28, v29 quad_perm:[0,1,2,3] row_mask:0xf bank_mask:0x2
    v_mov_b32_dpp v28, v30 quad_perm:[0,1,2,3] row_mask:0xf bank_mask:0x4
    v_mov_b32_dpp v28, v31 quad_perm:[0,1,2,3] row_mask:0xf bank_mask:0x8
    s_waitcnt vmcnt(7)
    v_mfma_f32_16x16x32_bf16 v[20:23], v[120:123], v[8:11], 0
    buffer_load_dwordx4 v[120:123], v1, s[8:11], s39 offen offset:0 nt
    v_add_f32_dpp v42, v25, v25 row_ror:4 row_mask:0xf bank_mask:0xf
    v_max3_f32 v36, v40, v42, v36
    v_add_f32_dpp v29, v28, v28 row_ror:8 row_mask:0xf bank_mask:0xf
    v_mov_b32_dpp v32, v33 quad_perm:[0,1,2,3] row_mask:0xf bank_mask:0x2
    v_mov_b32_dpp v32, v34 quad_perm:[0,1,2,3] row_mask:0xf bank_mask:0x4
    v_mov_b32_dpp v32, v35 quad_perm:[0,1,2,3] row_mask:0xf bank_mask:0x8
    s_waitcnt vmcnt(7)
    v_mfma_f32_16x16x32_bf16 v[24:27], v[124:127], v[8:11], 0
    buffer_load_dwordx4 v[124:127], v1, s[8:11], s39 offen offset:1024 nt
    v_add_f32_dpp v44, v29, v29 row_ror:4 row_mask:0xf bank_mask:0xf
    v_add_f32_dpp v33, v32, v32 row_ror:8 row_mask:0xf bank_mask:0xf
    v_mov_b32_dpp v20, v21 quad_perm:[0,1,2,3] row_mask:0xf bank_mask:0x2
    v_mov_b32_dpp v20, v22 quad_perm:[0,1,2,3] row_mask:0xf bank_mask:0x4
    v_mov_b32_dpp v20, v23 quad_perm:[0,1,2,3] row_mask:0xf bank_mask:0x8
    s_waitcnt vmcnt(7)
    v_mfma_f32_16x16x32_bf16 v[28:31], v[128:131], v[8:11], 0
    buffer_load_dwordx4 v[128:131], v1, s[8:11], s39 offen offset:2048 nt
    v_add_f32_dpp v46, v33, v33 row_ror:4 row_mask:0xf bank_mask:0xf
    v_max3_f32 v36, v44, v46, v36
    v_add_f32_dpp v21, v20, v20 row_ror:8 row_mask:0xf bank_mask:0xf
    v_mov_b32_dpp v24, v25 quad_perm:[0,1,2,3] row_mask:0xf bank_mask:0x2
    v_mov_b32_dpp v24, v26 quad_perm:[0,1,2,3] row_mask:0xf bank_mask:0x4
    v_mov_b32_dpp v24, v27 quad_perm:[0,1,2,3] row_mask:0xf bank_mask:0x8
    s_waitcnt vmcnt(7)
    v_mfma_f32_16x16x32_bf16 v[32:35], v[132:135], v[8:11], 0
    buffer_load_dwordx4 v[132:135], v1, s[8:11], s39 offen offset:3072 nt
    v_add_f32_dpp v48, v21, v21 row_ror:4 row_mask:0xf bank_mask:0xf
    v_add_f32_dpp v25, v24, v24 row_ror:8 row_mask:0xf bank_mask:0xf
    v_mov_b32_dpp v28, v29 quad_perm:[0,1,2,3] row_mask:0xf bank_mask:0x2
    v_mov_b32_dpp v28, v30 quad_perm:[0,1,2,3] row_mask:0xf bank_mask:0x4
    v_mov_b32_dpp v28, v31 quad_perm:[0,1,2,3] row_mask:0xf bank_mask:0x8
    s_waitcnt vmcnt(7)
    v_mfma_f32_16x16x32_bf16 v[20:23], v[104:107], v[8:11], 0
    buffer_load_dwordx4 v[104:107], v1, s[8:11], s40 offen offset:0 nt
    v_add_f32_dpp v50, v25, v25 row_ror:4 row_mask:0xf bank_mask:0xf
    v_max3_f32 v36, v48, v50, v36
    v_add_f32_dpp v29, v28, v28 row_ror:8 row_mask:0xf bank_mask:0xf
    v_mov_b32_dpp v32, v33 quad_perm:[0,1,2,3] row_mask:0xf bank_mask:0x2
    v_mov_b32_dpp v32, v34 quad_perm:[0,1,2,3] row_mask:0xf bank_mask:0x4
    v_mov_b32_dpp v32, v35 quad_perm:[0,1,2,3] row_mask:0xf bank_mask:0x8
    s_waitcnt vmcnt(7)
    v_mfma_f32_16x16x32_bf16 v[24:27], v[108:111], v[8:11], 0
    buffer_load_dwordx4 v[108:111], v1, s[8:11], s40 offen offset:1024 nt
    v_add_f32_dpp v52, v29, v29 row_ror:4 row_mask:0xf bank_mask:0xf
    v_add_f32_dpp v33, v32, v32 row_ror:8 row_mask:0xf bank_mask:0xf
    v_mov_b32_dpp v20, v21 quad_perm:[0,1,2,3] row_mask:0xf bank_mask:0x2
    v_mov_b32_dpp v20, v22 quad_perm:[0,1,2,3] row_mask:0xf bank_mask:0x4
    v_mov_b32_dpp v20, v23 quad_perm:[0,1,2,3] row_mask:0xf bank_mask:0x8
    s_waitcnt vmcnt(7)
    v_mfma_f32_16x16x32_bf16 v[28:31], v[112:115], v[8:11], 0
    buffer_load_dwordx4 v[112:115], v1, s[8:11], s40 offen offset:2048 nt
    v_add_f32_dpp v54, v33, v33 row_ror:4 row_mask:0xf bank_mask:0xf
    v_max3_f32 v36, v52, v54, v36
    v_add_f32_dpp v21, v20, v20 row_ror:8 row_mask:0xf bank_mask:0xf
    v_mov_b32_dpp v24, v25 quad_perm:[0,1,2,3] row_mask:0xf bank_mask:0x2
    v_mov_b32_dpp v24, v26 quad_perm:[0,1,2,3] row_mask:0xf bank_mask:0x4
    v_mov_b32_dpp v24, v27 quad_perm:[0,1,2,3] row_mask:0xf bank_mask:0x8
    s_waitcnt vmcnt(7)
    v_mfma_f32_16x16x32_bf16 v[32:35], v[116:119], v[8:11], 0
    buffer_load_dwordx4 v[116:119], v1, s[8:11], s40 offen offset:3072 nt
    v_add_f32_dpp v56, v21, v21 row_ror:4 row_mask:0xf bank_mask:0xf
    v_add_f32_dpp v25, v24, v24 row_ror:8 row_mask:0xf bank_mask:0xf
    v_mov_b32_dpp v28, v29 quad_perm:[0,1,2,3] row_mask:0xf bank_mask:0x2
    v_mov_b32_dpp v28, v30 quad_perm:[0,1,2,3] row_mask:0xf bank_mask:0x4
    v_mov_b32_dpp v28, v31 quad_perm:[0,1,2,3] row_mask:0xf bank_mask:0x8
    s_waitcnt vmcnt(7)
    v_mfma_f32_16x16x32_bf16 v[20:23], v[120:123], v[8:11], 0
    buffer_load_dwordx4 v[120:123], v1, s[8:11], s41 offen offset:0 nt
    v_add_f32_dpp v58, v25, v25 row_ror:4 row_mask:0xf bank_mask:0xf
    v_max3_f32 v36, v56, v58, v36
    v_add_f32_dpp v29, v28, v28 row_ror:8 row_mask:0xf bank_mask:0xf
    v_mov_b32_dpp v32, v33 quad_perm:[0,1,2,3] row_mask:0xf bank_mask:0x2
    v_mov_b32_dpp v32, v34 quad_perm:[0,1,2,3] row_mask:0xf bank_mask:0x4
    v_mov_b32_dpp v32, v35 quad_perm:[0,1,2,3] row_mask:0xf bank_mask:0x8
    s_cmp_lg_u32 s50, 0
    s_cbranch_scc0 L_tree
    v_mov_b32 v12, 0
    v_mov_b32 v13, 0
    v_mov_b32 v14, 0
    v_mov_b32 v15, 0
    v_mov_b32 v16, 0
    v_mov_b32 v17, 0
    v_mov_b32 v18, 0
    v_mov_b32 v19, 0
L_tree_ret:
    s_waitcnt vmcnt(7)
    v_mfma_f32_16x16x32_bf16 v[24:27], v[124:127], v[8:11], 0
    buffer_load_dwordx4 v[124:127], v1, s[8:11], s41 offen offset:1024 nt
    v_add_f32_dpp v60, v29, v29 row_ror:4 row_mask:0xf bank_mask:0xf
    v_add_f32_dpp v33, v32, v32 row_ror:8 row_mask:0xf bank_mask:0xf
    v_mov_b32_dpp v20, v21 quad_perm:[0,1,2,3] row_mask:0xf bank_mask:0x2
    v_mov_b32_dpp v20, v22 quad_perm:[0,1,2,3] row_mask:0xf bank_mask:0x4
    v_mov_b32_dpp v20, v23 quad_perm:[0,1,2,3] row_mask:0xf bank_mask:0x8
    s_waitcnt vmcnt(7)
    v_mfma_f32_16x16x32_bf16 v[28:31], v[128:131], v[8:11], 0
    buffer_load_dwordx4 v[128:131], v1, s[8:11], s41 offen offset:2048 nt
    v_add_f32_dpp v62, v33, v33 row_ror:4 row_mask:0xf bank_mask:0xf
    v_max3_f32 v36, v60, v62, v36
    v_add_f32_dpp v21, v20, v20 row_ror:8 row_mask:0xf bank_mask:0xf
    v_mov_b32_dpp v24, v25 quad_perm:[0,1,2,3] row_mask:0xf bank_mask:0x2
    v_mov_b32_dpp v24, v26 quad_perm:[0,1,2,3] row_mask:0xf bank_mask:0x4
    v_mov_b32_dpp v24, v27 quad_perm:[0,1,2,3] row_mask:0xf bank_mask:0x8
    s_waitcnt vmcnt(7)
    v_mfma_f32_16x16x32_bf16 v[32:35], v[132:135], v[8:11], 0
    buffer_load_dwordx4 v[132:135], v1, s[8:11], s41 offen offset:3072 nt
    v_add_f32_dpp v64, v21, v21 row_ror:4 row_mask:0xf bank_mask:0xf
    v_add_f32_dpp v25, v24, v24 row_ror:8 row_mask:0xf bank_mask:0xf
    v_mov_b32_dpp v28, v29 quad_perm:[0,1,2,3] row_mask:0xf bank_mask:0x2
    v_mov_b32_dpp v28, v30 quad_perm:[0,1,2,3] row_mask:0xf bank_mask:0x4
    v_mov_b32_dpp v28, v31 quad_perm:[0,1,2,3] row_mask:0xf bank_mask:0x8
    s_waitcnt vmcnt(7)
    v_mfma_f32_16x16x32_bf16 v[20:23], v[104:107], v[8:11], 0
    buffer_load_dwordx4 v[104:107], v1, s[8:11], s42 offen offset:0 nt
    v_add_f32_dpp v66, v25, v25 row_ror:4 row_mask:0xf bank_mask:0xf
    v_max3_f32 v36, v64, v66, v36
    v_add_f32_dpp v29, v28, v28 row_ror:8 row_mask:0xf bank_mask:0xf
    v_mov_b32_dpp v32, v33 quad_perm:[0,1,2,3] row_mask:0xf bank_mask:0x2
    v_mov_b32_dpp v32, v34 quad_perm:[0,1,2,3] row_mask:0xf bank_mask:0x4
    v_mov_b32_dpp v32, v35 quad_perm:[0,1,2,3] row_mask:0xf bank_mask:0x8
    s_waitcnt vmcnt(7)
    v_mfma_f32_16x16x32_bf16 v[24:27], v[108:111], v[8:11], 0
    buffer_load_dwordx4 v[108:111], v1, s[8:11], s42 offen offset:1024 nt
    v_add_f32_dpp v68, v29, v29 row_ror:4 row_mask:0xf bank_mask:0xf
    v_add_f32_dpp v33, v32, v32 row_ror:8 row_mask:0xf bank_mask:0xf
    v_mov_b32_dpp v20, v21 quad_perm:[0,1,2,3] row_mask:0xf bank_mask:0x2
    v_mov_b32_dpp v20, v22 quad_perm:[0,1,2,3] row_mask:0xf bank_mask:0x4
    v_mov_b32_dpp v20, v23 quad_perm:[0,1,2,3] row_mask:0xf bank_mask:0x8
    s_waitcnt vmcnt(7)
    v_mfma_f32_16x16x32_bf16 v[28:31], v[112:115], v[8:11], 0
    buffer_load_dwordx4 v[112:115], v1, s[8:11], s42 offen offset:2048 nt
    v_add_f32_dpp v70, v33, v33 row_ror:4 row_mask:0xf bank_mask:0xf
    v_max3_f32 v36, v68, v70, v36
    v_add_f32_dpp v21, v20, v20 row_ror:8 row_mask:0xf bank_mask:0xf
    v_mov_b32_dpp v24, v25 quad_perm:[0,1,2,3] row_mask:0xf bank_mask:0x2
    v_mov_b32_dpp v24, v26 quad_perm:[0,1,2,3] row_mask:0xf bank_mask:0x4
    v_mov_b32_dpp v24, v27 quad_perm:[0,1,2,3] row_mask:0xf bank_mask:0x8
    s_waitcnt vmcnt(7)
    v_mfma_f32_16x16x32_bf16 v[32:35], v[116:119], v[8:11], 0
    buffer_load_dwordx4 v[116:119], v1, s[8:11], s42 offen offset:3072 nt
    v_add_f32_dpp v72, v21, v21 row_ror:4 row_mask:0xf bank_mask:0xf
    v_add_f32_dpp v25, v24, v24 row_ror:8 row_mask:0xf bank_mask:0xf
    v_mov_b32_dpp v28, v29 quad_perm:[0,1,2,3] row_mask:0xf bank_mask:0x2
    v_mov_b32_dpp v28, v30 quad_perm:[0,1,2,3] row_mask:0xf bank_mask:0x4
    v_mov_b32_dpp v28, v31 quad_perm:[0,1,2,3] row_mask:0xf bank_mask:0x8
    s_waitcnt vmcnt(7)
    v_mfma_f32_16x16x32_bf16 v[20:23], v[120:123], v[8:11], 0
    buffer_load_dwordx4 v[120:123], v1, s[8:11], s43 offen offset:0 nt
    v_add_f32_dpp v74, v25, v25 row_ror:4 row_mask:0xf bank_mask:0xf
    v_max3_f32 v36, v72, v74, v36
    v_add_f32_dpp v29, v28, v28 row_ror:8 row_mask:0xf bank_mask:0xf
    v_mov_b32_dpp v32, v33 quad_perm:[0,1,2,3] row_mask:0xf bank_mask:0x2
    v_mov_b32_dpp v32, v34 quad_perm:[0,1,2,3] row_mask:0xf bank_mask:0x4
    v_mov_b32_dpp v32, v35 quad_perm:[0,1,2,3] row_mask:0xf bank_mask:0x8
    s_waitcnt vmcnt(7)
    v_mfma_f32_16x16x32_bf16 v[24:27], v[124:127], v[8:11], 0
    buffer_load_dwordx4 v[124:127], v1, s[8:11], s43 offen offset:1024 nt
    v_add_f32_dpp v76, v29, v29 row_ror:4 row_mask:0xf bank_mask:0xf
    v_add_f32_dpp v33, v32, v32 row_ror:8 row_mask:0xf bank_mask:0xf
    v_mov_b32_dpp v20, v21 quad_perm:[0,1,2,3] row_mask:0xf bank_mask:0x2
    v_mov_b32_dpp v20, v22 quad_perm:[0,1,2,3] row_mask:0xf bank_mask:0x4
    v_mov_b32_dpp v20, v23 quad_perm:[0,1,2,3] row_mask:0xf bank_mask:0x8
    s_waitcnt vmcnt(7)
    v_mfma_f32_16x16x32_bf16 v[28:31], v[128:131], v[8:11], 0
    buffer_load_dwordx4 v[128:131], v1, s[8:11], s43 offen offset:2048 nt
    v_add_f32_dpp v78, v33, v33 row_ror:4 row_mask:0xf bank_mask:0xf
    v_max3_f32 v36, v76, v78, v36
    v_add_f32_dpp v21, v20, v20 row_ror:8 row_mask:0xf bank_mask:0xf
    v_mov_b32_dpp v24, v25 quad_perm:[0,1,2,3] row_mask:0xf bank_mask:0x2
    v_mov_b32_dpp v24, v26 quad_perm:[0,1,2,3] row_mask:0xf bank_mask:0x4
    v_mov_b32_dpp v24, v27 quad_perm:[0,1,2,3] row_mask:0xf bank_mask:0x8
    s_waitcnt vmcnt(7)
    v_mfma_f32_16x16x32_bf16 v[32:35], v[132:135], v[8:11], 0
    buffer_load_dwordx4 v[132:135], v1, s[8:11], s43 offen offset:3072 nt
    v_add_f32_dpp v80, v21, v21 row_ror:4 row_mask:0xf bank_mask:0xf
    v_add_f32_dpp v25, v24, v24 row_ror:8 row_mask:0xf bank_mask:0xf
    v_mov_b32_dpp v28, v29 quad_perm:[0,1,2,3] row_mask:0xf bank_mask:0x2
    v_mov_b32_dpp v28, v30 quad_perm:[0,1,2,3] row_mask:0xf bank_mask:0x4
    v_mov_b32_dpp v28, v31 quad_perm:[0,1,2,3] row_mask:0xf bank_mask:0x8
    s_waitcnt vmcnt(7)
    v_mfma_f32_16x16x32_bf16 v[20:23], v[104:107], v[8:11], 0
    buffer_load_dwordx4 v[104:107], v2, s[12:15], 0 offen offset:0 nt
    v_add_f32_dpp v82, v25, v25 row_ror:4 row_mask:0xf bank_mask:0xf
    v_max3_f32 v36, v80, v82, v36
    v_add_f32_dpp v29, v28, v28 row_ror:8 row_mask:0xf bank_mask:0xf
    v_mov_b32_dpp v32, v33 quad_perm:[0,1,2,3] row_mask:0xf bank_mask:0x2
    v_mov_b32_dpp v32, v34 quad_perm:[0,1,2,3] row_mask:0xf bank_mask:0x4
    v_mov_b32_dpp v32, v35 quad_perm:[0,1,2,3] row_mask:0xf bank_mask:0x8
    s_waitcnt vmcnt(7)
    v_mfma_f32_16x16x32_bf16 v[24:27], v[108:111], v[8:11], 0
    buffer_load_dwordx4 v[108:111], v2, s[12:15], 0 offen offset:1024 nt
    v_add_f32_dpp v84, v29, v29 row_ror:4 row_mask:0xf bank_mask:0xf
    v_add_f32_dpp v33, v32, v32 row_ror:8 row_mask:0xf bank_mask:0xf
    v_mov_b32_dpp v20, v21 quad_perm:[0,1,2,3] row_mask:0xf bank_mask:0x2
    v_mov_b32_dpp v20, v22 quad_perm:[0,1,2,3] row_mask:0xf bank_mask:0x4
    v_mov_b32_dpp v20, v23 quad_perm:[0,1,2,3] row_mask:0xf bank_mask:0x8
    s_waitcnt vmcnt(7)
    v_mfma_f32_16x16x32_bf16 v[28:31], v[112:115], v[8:11], 0
    buffer_load_dwordx4 v[112:115], v2, s[12:15], 0 offen offset:2048 nt
    v_add_f32_dpp v86, v33, v33 row_ror:4 row_mask:0xf bank_mask:0xf
    v_max3_f32 v36, v84, v86, v36
    v_add_f32_dpp v21, v20, v20 row_ror:8 row_mask:0xf bank_mask:0xf
    v_mov_b32_dpp v24, v25 quad_perm:[0,1,2,3] row_mask:0xf bank_mask:0x2
    v_mov_b32_dpp v24, v26 quad_perm:[0,1,2,3] row_mask:0xf bank_mask:0x4
    v_mov_b32_dpp v24, v27 quad_perm:[0,1,2,3] row_mask:0xf bank_mask:0x8
    s_waitcnt vmcnt(7)
    v_mfma_f32_16x16x32_bf16 v[32:35], v[116:119], v[8:11], 0
    buffer_load_dwordx4 v[116:119], v2, s[12:15], 0 offen offset:3072 nt
    v_add_f32_dpp v88, v21, v21 row_ror:4 row_mask:0xf bank_mask:0xf
    v_add_f32_dpp v25, v24, v24 row_ror:8 row_mask:0xf bank_mask:0xf
    v_mov_b32_dpp v28, v29 quad_perm:[0,1,2,3] row_mask:0xf bank_mask:0x2
    v_mov_b32_dpp v28, v30 quad_perm:[0,1,2,3] row_mask:0xf bank_mask:0x4
    v_mov_b32_dpp v28, v31 quad_perm:[0,1,2,3] row_mask:0xf bank_mask:0x8
    s_waitcnt vmcnt(7)
    v_mfma_f32_16x16x32_bf16 v[20:23], v[120:123], v[8:11], 0
    buffer_load_dwordx4 v[120:123], v2, s[12:15], s37 offen offset:0 nt
    v_add_f32_dpp v90, v25, v25 row_ror:4 row_mask:0xf bank_mask:0xf
    v_max3_f32 v36, v88, v90, v36
    v_add_f32_dpp v29, v28, v28 row_ror:8 row_mask:0xf bank_mask:0xf
    v_mov_b32_dpp v32, v33 quad_perm:[0,1,2,3] row_mask:0xf bank_mask:0x2
    v_mov_b32_dpp v32, v34 quad_perm:[0,1,2,3] row_mask:0xf bank_mask:0x4
    v_mov_b32_dpp v32, v35 quad_perm:[0,1,2,3] row_mask:0xf bank_mask:0x8
    s_waitcnt vmcnt(7)
    v_mfma_f32_16x16x32_bf16 v[24:27], v[124:127], v[8:11], 0
    buffer_load_dwordx4 v[124:127], v2, s[12:15], s37 offen offset:1024 nt
    v_add_f32_dpp v92, v29, v29 row_ror:4 row_mask:0xf bank_mask:0xf
    v_add_f32_dpp v33, v32, v32 row_ror:8 row_mask:0xf bank_mask:0xf
    v_mov_b32_dpp v20, v21 quad_perm:[0,1,2,3] row_mask:0xf bank_mask:0x2
    v_mov_b32_dpp v20, v22 quad_perm:[0,1,2,3] row_mask:0xf bank_mask:0x4
    v_mov_b32_dpp v20, v23 quad_perm:[0,1,2,3] row_mask:0xf bank_mask:0x8
    s_waitcnt vmcnt(7)
    v_mfma_f32_16x16x32_bf16 v[28:31], v[128:131], v[8:11], 0
    buffer_load_dwordx4 v[128:131], v2, s[12:15], s37 offen offset:2048 nt
    v_add_f32_dpp v94, v33, v33 row_ror:4 row_mask:0xf bank_mask:0xf
    v_max3_f32 v36, v92, v94, v36
    v_add_f32_dpp v21, v20, v20 row_ror:8 row_mask:0xf bank_mask:0xf
    v_mov_b32_dpp v24, v25 quad_perm:[0,1,2,3] row_mask:0xf bank_mask:0x2
    v_mov_b32_dpp v24, v26 quad_perm:[0,1,2,3] row_mask:0xf bank_mask:0x4
    v_mov_b32_dpp v24, v27 quad_perm:[0,1,2,3] row_mask:0xf bank_mask:0x8
    s_waitcnt vmcnt(7)
    v_mfma_f32_16x16x32_bf16 v[32:35], v[132:135], v[8:11], 0
    buffer_load_dwordx4 v[132:135], v2, s[12:15], s37 offen offset:3072 nt
    v_add_f32_dpp v96, v21, v21 row_ror:4 row_mask:0xf bank_mask:0xf
    v_add_f32_dpp v25, v24, v24 row_ror:8 row_mask:0xf bank_mask:0xf
    v_mov_b32_dpp v28, v29 quad_perm:[0,1,2,3] row_mask:0xf bank_mask:0x2
    v_mov_b32_dpp v28, v30 quad_perm:[0,1,2,3] row_mask:0xf bank_mask:0x4
    v_mov_b32_dpp v28, v31 quad_perm:[0,1,2,3] row_mask:0xf bank_mask:0x8
    v_add_f32_dpp v98, v25, v25 row_ror:4 row_mask:0xf bank_mask:0xf
    v_max3_f32 v36, v96, v98, v36
    v_add_f32_dpp v29, v28, v28 row_ror:8 row_mask:0xf bank_mask:0xf
    v_mov_b32_dpp v32, v33 quad_perm:[0,1,2,3] row_mask:0xf bank_mask:0x2
    v_mov_b32_dpp v32, v34 quad_perm:[0,1,2,3] row_mask:0xf bank_mask:0x4
    v_mov_b32_dpp v32, v35 quad_perm:[0,1,2,3] row_mask:0xf bank_mask:0x8
    v_add_f32_dpp v100, v29, v29 row_ror:4 row_mask:0xf bank_mask:0xf
    s_nop 0
    v_add_f32_dpp v33, v32, v32 row_ror:8 row_mask:0xf bank_mask:0xf
    s_nop 1
    v_add_f32_dpp v102, v33, v33 row_ror:4 row_mask:0xf bank_mask:0xf
    v_max3_f32 v36, v100, v102, v36
    v_mov_b32 v37, v36
    s_nop 1
    v_permlane32_swap_b32 v36, v37
    v_max_f32 v36, v36, v37
    v_mov_b32 v37, v36
    s_nop 1
    v_permlane16_swap_b32 v36, v37
    v_max_f32 v36, v36, v37
    v_mul_f32 v6, s49, v36
    v_mov_b32 v7, 0
    s_cmp_lg_u32 s50, 0
    s_cbranch_scc0 L_tree_acc
L_tree_acc_done:
    v_fma_f32 v40, v40, s49, -v6
    v_fma_f32 v42, v42, s49, -v6
    v_exp_f32 v40, v40
    v_exp_f32 v42, v42
    v_cvt_pk_bf16_f32 v20, v40, v40
    v_cvt_pk_bf16_f32 v21, v42, v42
    v_add_f32 v7, v7, v40
    v_add_f32 v7, v7, v42
    v_and_b32 v40, v20, v4
    v_and_b32 v41, v20, v5
    v_and_b32 v42, v21, v4
    v_and_b32 v43, v21, v5
    s_waitcnt vmcnt(7)
    v_mfma_f32_16x16x16_bf16 v[12:15], v[40:41], v[104:105], v[12:15]
    v_mfma_f32_16x16x16_bf16 v[16:19], v[40:41], v[106:107], v[16:19]
    buffer_load_dwordx4 v[104:107], v2, s[12:15], s38 offen offset:0 nt
    v_fma_f32 v44, v44, s49, -v6
    v_fma_f32 v46, v46, s49, -v6
    v_exp_f32 v44, v44
    v_exp_f32 v46, v46
    v_cvt_pk_bf16_f32 v22, v44, v44
    v_cvt_pk_bf16_f32 v23, v46, v46
    v_add_f32 v7, v7, v44
    v_add_f32 v7, v7, v46
    v_and_b32 v44, v22, v4
    v_and_b32 v45, v22, v5
    v_and_b32 v46, v23, v4
    v_and_b32 v47, v23, v5
    s_waitcnt vmcnt(7)
    v_mfma_f32_16x16x16_bf16 v[12:15], v[42:43], v[108:109], v[12:15]
    v_mfma_f32_16x16x16_bf16 v[16:19], v[42:43], v[110:111], v[16:19]
    buffer_load_dwordx4 v[108:111], v2, s[12:15], s38 offen offset:1024 nt
    v_fma_f32 v48, v48, s49, -v6
    v_fma_f32 v50, v50, s49, -v6
    v_exp_f32 v48, v48
    v_exp_f32 v50, v50
    v_cvt_pk_bf16_f32 v24, v48, v48
    v_cvt_pk_bf16_f32 v25, v50, v50
    v_add_f32 v7, v7, v48
    v_add_f32 v7, v7, v50
    v_and_b32 v48, v24, v4
    v_and_b32 v49, v24, v5
    v_and_b32 v50, v25, v4
    v_and_b32 v51, v25, v5
    s_waitcnt vmcnt(7)
    v_mfma_f32_16x16x16_bf16 v[12:15], v[44:45], v[112:113], v[12:15]
    v_mfma_f32_16x16x16_bf16 v[16:19], v[44:45], v[114:115], v[16:19]
    buffer_load_dwordx4 v[112:115], v2, s[12:15], s38 offen offset:2048 nt
    v_fma_f32 v52, v52, s49, -v6
    v_fma_f32 v54, v54, s49, -v6
    v_exp_f32 v52, v52
    v_exp_f32 v54, v54
    v_cvt_pk_bf16_f32 v26, v52, v52
    v_cvt_pk_bf16_f32 v27, v54, v54
    v_add_f32 v7, v7, v52
    v_add_f32 v7, v7, v54
    v_and_b32 v52, v26, v4
    v_and_b32 v53, v26, v5
    v_and_b32 v54, v27, v4
    v_and_b32 v55, v27, v5
    s_waitcnt vmcnt(7)
    v_mfma_f32_16x16x16_bf16 v[12:15], v[46:47], v[116:117], v[12:15]
    v_mfma_f32_16x16x16_bf16 v[16:19], v[46:47], v[118:119], v[16:19]
    buffer_load_dwordx4 v[116:119], v2, s[12:15], s38 offen offset:3072 nt
    v_fma_f32 v56, v56, s49, -v6
    v_fma_f32 v58, v58, s49, -v6
    v_exp_f32 v56, v56
    v_exp_f32 v58, v58
    v_cvt_pk_bf16_f32 v20, v56, v56
    v_cvt_pk_bf16_f32 v21, v58, v58
    v_add_f32 v7, v7, v56
    v_add_f32 v7, v7, v58
    v_and_b32 v56, v20, v4
    v_and_b32 v57, v20, v5
    v_and_b32 v58, v21, v4
    v_and_b32 v59, v21, v5
    s_waitcnt vmcnt(7)
    v_mfma_f32_16x16x16_bf16 v[12:15], v[48:49], v[120:121], v[12:15]
    v_mfma_f32_16x16x16_bf16 v[16:19], v[48:49], v[122:123], v[16:19]
    buffer_load_dwordx4 v[120:123], v2, s[12:15], s39 offen offset:0 nt
    v_fma_f32 v60, v60, s49, -v6
    v_fma_f32 v62, v62, s49, -v6
    v_exp_f32 v60, v60
    v_exp_f32 v62, v62
    v_cvt_pk_bf16_f32 v22, v60, v60
    v_cvt_pk_bf16_f32 v23, v62, v62
    v_add_f32 v7, v7, v60
    v_add_f32 v7, v7, v62
    v_and_b32 v60, v22, v4
    v_and_b32 v61, v22, v5
    v_and_b32 v62, v23, v4
    v_and_b32 v63, v23, v5
    s_waitcnt vmcnt(7)
    v_mfma_f32_16x16x16_bf16 v[12:15], v[50:51], v[124:125], v[12:15]
    v_mfma_f32_16x16x16_bf16 v[16:19], v[50:51], v[126:127], v[16:19]
    buffer_load_dwordx4 v[124:127], v2, s[12:15], s39 offen offset:1024 nt
    v_fma_f32 v64, v64, s49, -v6
    v_fma_f32 v66, v66, s49, -v6
    v_exp_f32 v64, v64
    v_exp_f32 v66, v66
    v_cvt_pk_bf16_f32 v24, v64, v64
    v_cvt_pk_bf16_f32 v25, v66, v66
    v_add_f32 v7, v7, v64
    v_add_f32 v7, v7, v66
    v_and_b32 v64, v24, v4
    v_and_b32 v65, v24, v5
    v_and_b32 v66, v25, v4
    v_and_b32 v67, v25, v5
    s_waitcnt vmcnt(7)
    v_mfma_f32_16x16x16_bf16 v[12:15], v[52:53], v[128:129], v[12:15]
    v_mfma_f32_16x16x16_bf16 v[16:19], v[52:53], v[130:131], v[16:19]
    buffer_load_dwordx4 v[128:131], v2, s[12:15], s39 offen offset:2048 nt
    v_fma_f32 v68, v68, s49, -v6
    v_fma_f32 v70, v70, s49, -v6
    v_exp_f32 v68, v68
    v_exp_f32 v70, v70
    v_cvt_pk_bf16_f32 v26, v68, v68
    v_cvt_pk_bf16_f32 v27, v70, v70
    v_add_f32 v7, v7, v68
    v_add_f32 v7, v7, v70
    v_and_b32 v68, v26, v4
    v_and_b32 v69, v26, v5
    v_and_b32 v70, v27, v4
    v_and_b32 v71, v27, v5
    s_waitcnt vmcnt(7)
    v_mfma_f32_16x16x16_bf16 v[12:15], v[54:55], v[132:133], v[12:15]
    v_mfma_f32_16x16x16_bf16 v[16:19], v[54:55], v[134:135], v[16:19]
    buffer_load_dwordx4 v[132:135], v2, s[12:15], s39 offen offset:3072 nt
    v_fma_f32 v72, v72, s49, -v6
    v_fma_f32 v74, v74, s49, -v6
    v_exp_f32 v72, v72
    v_exp_f32 v74, v74
    v_cvt_pk_bf16_f32 v20, v72, v72
    v_cvt_pk_bf16_f32 v21, v74, v74
    v_add_f32 v7, v7, v72
    v_add_f32 v7, v7, v74
    v_and_b32 v72, v20, v4
    v_and_b32 v73, v20, v5
    v_and_b32 v74, v21, v4
    v_and_b32 v75, v21, v5
    s_waitcnt vmcnt(7)
    v_mfma_f32_16x16x16_bf16 v[12:15], v[56:57], v[104:105], v[12:15]
    v_mfma_f32_16x16x16_bf16 v[16:19], v[56:57], v[106:107], v[16:19]
    buffer_load_dwordx4 v[104:107], v2, s[12:15], s40 offen offset:0 nt
    v_fma_f32 v76, v76, s49, -v6
    v_fma_f32 v78, v78, s49, -v6
    v_exp_f32 v76, v76
    v_exp_f32 v78, v78
    v_cvt_pk_bf16_f32 v22, v76, v76
    v_cvt_pk_bf16_f32 v23, v78, v78
    v_add_f32 v7, v7, v76
    v_add_f32 v7, v7, v78
    v_and_b32 v76, v22, v4
    v_and_b32 v77, v22, v5
    v_and_b32 v78, v23, v4
    v_and_b32 v79, v23, v5
    s_waitcnt vmcnt(7)
    v_mfma_f32_16x16x16_bf16 v[12:15], v[58:59], v[108:109], v[12:15]
    v_mfma_f32_16x16x16_bf16 v[16:19], v[58:59], v[110:111], v[16:19]
    buffer_load_dwordx4 v[108:111], v2, s[12:15], s40 offen offset:1024 nt
    v_fma_f32 v80, v80, s49, -v6
    v_fma_f32 v82, v82, s49, -v6
    v_exp_f32 v80, v80
    v_exp_f32 v82, v82
    v_cvt_pk_bf16_f32 v24, v80, v80
    v_cvt_pk_bf16_f32 v25, v82, v82
    v_add_f32 v7, v7, v80
    v_add_f32 v7, v7, v82
    v_and_b32 v80, v24, v4
    v_and_b32 v81, v24, v5
    v_and_b32 v82, v25, v4
    v_and_b32 v83, v25, v5
    s_waitcnt vmcnt(7)
    v_mfma_f32_16x16x16_bf16 v[12:15], v[60:61], v[112:113], v[12:15]
    v_mfma_f32_16x16x16_bf16 v[16:19], v[60:61], v[114:115], v[16:19]
    buffer_load_dwordx4 v[112:115], v2, s[12:15], s40 offen offset:2048 nt
    v_fma_f32 v84, v84, s49, -v6
    v_fma_f32 v86, v86, s49, -v6
    v_exp_f32 v84, v84
    v_exp_f32 v86, v86
    v_cvt_pk_bf16_f32 v26, v84, v84
    v_cvt_pk_bf16_f32 v27, v86, v86
    v_add_f32 v7, v7, v84
    v_add_f32 v7, v7, v86
    v_and_b32 v84, v26, v4
    v_and_b32 v85, v26, v5
    v_and_b32 v86, v27, v4
    v_and_b32 v87, v27, v5
    s_waitcnt vmcnt(7)
    v_mfma_f32_16x16x16_bf16 v[12:15], v[62:63], v[116:117], v[12:15]
    v_mfma_f32_16x16x16_bf16 v[16:19], v[62:63], v[118:119], v[16:19]
    buffer_load_dwordx4 v[116:119], v2, s[12:15], s40 offen offset:3072 nt
    v_fma_f32 v88, v88, s49, -v6
    v_fma_f32 v90, v90, s49, -v6
    v_exp_f32 v88, v88
    v_exp_f32 v90, v90
    v_cvt_pk_bf16_f32 v20, v88, v88
    v_cvt_pk_bf16_f32 v21, v90, v90
    v_add_f32 v7, v7, v88
    v_add_f32 v7, v7, v90
    v_and_b32 v88, v20, v4
    v_and_b32 v89, v20, v5
    v_and_b32 v90, v21, v4
    v_and_b32 v91, v21, v5
    s_waitcnt vmcnt(7)
    v_mfma_f32_16x16x16_bf16 v[12:15], v[64:65], v[120:121], v[12:15]
    v_mfma_f32_16x16x16_bf16 v[16:19], v[64:65], v[122:123], v[16:19]
    buffer_load_dwordx4 v[120:123], v2, s[12:15], s41 offen offset:0 nt
    v_fma_f32 v92, v92, s49, -v6
    v_fma_f32 v94, v94, s49, -v6
    v_exp_f32 v92, v92
    v_exp_f32 v94, v94
    v_cvt_pk_bf16_f32 v22, v92, v92
    v_cvt_pk_bf16_f32 v23, v94, v94
    v_add_f32 v7, v7, v92
    v_add_f32 v7, v7, v94
    v_and_b32 v92, v22, v4
    v_and_b32 v93, v22, v5
    v_and_b32 v94, v23, v4
    v_and_b32 v95, v23, v5
    s_waitcnt vmcnt(7)
    v_mfma_f32_16x16x16_bf16 v[12:15], v[66:67], v[124:125], v[12:15]
    v_mfma_f32_16x16x16_bf16 v[16:19], v[66:67], v[126:127], v[16:19]
    buffer_load_dwordx4 v[124:127], v2, s[12:15], s41 offen offset:1024 nt
    v_fma_f32 v96, v96, s49, -v6
    v_fma_f32 v98, v98, s49, -v6
    v_exp_f32 v96, v96
    v_exp_f32 v98, v98
    v_cvt_pk_bf16_f32 v24, v96, v96
    v_cvt_pk_bf16_f32 v25, v98, v98
    v_add_f32 v7, v7, v96
    v_add_f32 v7, v7, v98
    v_and_b32 v96, v24, v4
    v_and_b32 v97, v24, v5
    v_and_b32 v98, v25, v4
    v_and_b32 v99, v25, v5
    s_waitcnt vmcnt(7)
    v_mfma_f32_16x16x16_bf16 v[12:15], v[68:69], v[128:129], v[12:15]
    v_mfma_f32_16x16x16_bf16 v[16:19], v[68:69], v[130:131], v[16:19]
    buffer_load_dwordx4 v[128:131], v2, s[12:15], s41 offen offset:2048 nt
    v_fma_f32 v100, v100, s49, -v6
    v_fma_f32 v102, v102, s49, -v6
    v_exp_f32 v100, v100
    v_exp_f32 v102, v102
    v_cvt_pk_bf16_f32 v26, v100, v100
    v_cvt_pk_bf16_f32 v27, v102, v102
    v_add_f32 v7, v7, v100
    v_add_f32 v7, v7, v102
    v_and_b32 v100, v26, v4
    v_and_b32 v101, v26, v5
    v_and_b32 v102, v27, v4
    v_and_b32 v103, v27, v5
    s_waitcnt vmcnt(7)
    v_mfma_f32_16x16x16_bf16 v[12:15], v[70:71], v[132:133], v[12:15]
    v_mfma_f32_16x16x16_bf16 v[16:19], v[70:71], v[134:135], v[16:19]
    buffer_load_dwordx4 v[132:135], v2, s[12:15], s41 offen offset:3072 nt
    v_mov_b32 v37, v7
    v_and_b32 v20, 3, v0
    v_lshrrev_b32 v21, 6, v0
    v_permlane32_swap_b32 v7, v37
    v_lshlrev_b32 v20, 3, v20
    v_add_f32 v7, v7, v37
    v_mov_b32 v37, v7
    v_lshl_add_u32 v22, v21, 5, v20
    v_lshlrev_b32 v23, 11, v21
    v_permlane16_swap_b32 v7, v37
    v_and_b32 v24, 63, v0
    v_add_f32 v7, v7, v37
    v_lshl_add_u32 v36, v24, 4, v23
    v_mov_b32 v1, v20
    ds_write_b64 v22, v[6:7] offset:0
    s_waitcnt vmcnt(7)
    v_mfma_f32_16x16x16_bf16 v[12:15], v[72:73], v[104:105], v[12:15]
    v_mfma_f32_16x16x16_bf16 v[16:19], v[72:73], v[106:107], v[16:19]
    buffer_load_dwordx4 v[104:107], v2, s[12:15], s42 offen offset:0 nt
    s_waitcnt vmcnt(7)
    v_mfma_f32_16x16x16_bf16 v[12:15], v[74:75], v[108:109], v[12:15]
    v_mfma_f32_16x16x16_bf16 v[16:19], v[74:75], v[110:111], v[16:19]
    buffer_load_dwordx4 v[108:111], v2, s[12:15], s42 offen offset:1024 nt
    s_waitcnt vmcnt(7)
    v_mfma_f32_16x16x16_bf16 v[12:15], v[76:77], v[112:113], v[12:15]
    v_mfma_f32_16x16x16_bf16 v[16:19], v[76:77], v[114:115], v[16:19]
    buffer_load_dwordx4 v[112:115], v2, s[12:15], s42 offen offset:2048 nt
    s_waitcnt vmcnt(7)
    v_mfma_f32_16x16x16_bf16 v[12:15], v[78:79], v[116:117], v[12:15]
    v_mfma_f32_16x16x16_bf16 v[16:19], v[78:79], v[118:119], v[16:19]
    buffer_load_dwordx4 v[116:119], v2, s[12:15], s42 offen offset:3072 nt
    s_waitcnt vmcnt(7)
    v_mfma_f32_16x16x16_bf16 v[12:15], v[80:81], v[120:121], v[12:15]
    v_mfma_f32_16x16x16_bf16 v[16:19], v[80:81], v[122:123], v[16:19]
    buffer_load_dwordx4 v[120:123], v2, s[12:15], s43 offen offset:0 nt
    s_waitcnt vmcnt(7)
    v_mfma_f32_16x16x16_bf16 v[12:15], v[82:83], v[124:125], v[12:15]
    v_mfma_f32_16x16x16_bf16 v[16:19], v[82:83], v[126:127], v[16:19]
    buffer_load_dwordx4 v[124:127], v2, s[12:15], s43 offen offset:1024 nt
    s_waitcnt vmcnt(7)
    v_mfma_f32_16x16x16_bf16 v[12:15], v[84:85], v[128:129], v[12:15]
    v_mfma_f32_16x16x16_bf16 v[16:19], v[84:85], v[130:131], v[16:19]
    buffer_load_dwordx4 v[128:131], v2, s[12:15], s43 offen offset:2048 nt
    s_waitcnt vmcnt(7)
    v_mfma_f32_16x16x16_bf16 v[12:15], v[86:87], v[132:133], v[12:15]
    v_mfma_f32_16x16x16_bf16 v[16:19], v[86:87], v[134:135], v[16:19]
    buffer_load_dwordx4 v[132:135], v2, s[12:15], s43 offen offset:3072 nt
    s_waitcnt lgkmcnt(0)
    s_barrier
    ds_read_b64 v[20:21], v1 offset:0
    ds_read_b64 v[22:23], v1 offset:32
    ds_read_b64 v[24:25], v1 offset:64
    ds_read_b64 v[26:27], v1 offset:96
    s_mul_i32 s56, s55, 0x9E3779B1
    s_add_u32 s56, s56, 0x7F4A7C15
    s_mul_i32 s92, s92, 0x9E3779B1
    s_add_u32 s92, s92, 0x7F4A7C15
    s_mul_i32 s93, s93, 0x9E3779B1
    s_add_u32 s93, s93, 0x7F4A7C15
    s_mul_i32 s94, s94, 0x9E3779B1
    s_add_u32 s94, s94, 0x7F4A7C15
    s_mul_i32 s95, s95, 0x9E3779B1
    s_add_u32 s95, s95, 0x7F4A7C15
    v_mov_b32 v47, s92
    v_mov_b32 v45, s93
    s_nop 1
    v_mov_b32_dpp v47, v45 quad_perm:[0,1,2,3] row_mask:0x2 bank_mask:0xf
    v_mov_b32 v44, s94
    s_nop 1
    v_mov_b32_dpp v47, v44 quad_perm:[0,1,2,3] row_mask:0x4 bank_mask:0xf
    v_mov_b32 v45, s95
    s_nop 1
    v_mov_b32_dpp v47, v45 quad_perm:[0,1,2,3] row_mask:0x8 bank_mask:0xf
    v_lshrrev_b32 v42, 4, v0
    v_and_b32 v43, 15, v0
    v_lshlrev_b32 v42, 12, v42
    v_lshl_add_u32 v42, v43, 4, v42
    s_lshl_b32 s57, s34, 16
    s_lshl_b32 s58, s35, 8
    s_add_u32 s58, s58, s57
    s_lshl_b32 s59, s35, 12
    s_lshl_b32 s57, s65, 16
    s_add_u32 s59, s59, s57
    v_lshlrev_b32 v43, 2, v0
    v_add_u32 v43, 128, v43
    v_lshlrev_b32 v1, 4, v0
    v_mov_b32 v2, s56
    v_and_b32 v37, 3, v0
    v_lshlrev_b32 v37, 8, v37
    v_bfe_u32 v44, v0, 2, 2
    v_lshl_add_u32 v37, v44, 4, v37
    v_bfe_u32 v44, v0, 5, 1
    v_lshl_add_u32 v37, v44, 3, v37
    s_and_b32 s66, s35, 3
    s_lshl_b32 s66, s66, 6
    s_lshr_b32 s64, s35, 2
    s_lshl_b32 s64, s64, 1
    s_add_u32 s66, s66, s64
    s_mov_b32 s64, 200000
    s_waitcnt lgkmcnt(0)
    v_max3_f32 v40, v20, v22, v24
    v_max_f32 v40, v40, v26
    v_sub_f32 v20, v20, v40
    v_sub_f32 v22, v22, v40
    v_sub_f32 v24, v24, v40
    v_sub_f32 v26, v26, v40
    v_exp_f32 v20, v20
    v_exp_f32 v22, v22
    v_exp_f32 v24, v24
    v_exp_f32 v26, v26
    v_mul_f32 v41, v20, v21
    v_fmac_f32 v41, v22, v23
    v_fmac_f32 v41, v24, v25
    v_fmac_f32 v41, v26, v27
    v_rcp_f32 v21, v41
    v_log_f32 v23, v41
    s_nop 0
    v_mul_f32 v20, v20, v21
    v_mul_f32 v22, v22, v21
    v_mul_f32 v24, v24, v21
    v_mul_f32 v26, v26, v21
    v_add_f32 v46, v23, v40
    s_waitcnt vmcnt(7)
    v_mfma_f32_16x16x16_bf16 v[12:15], v[88:89], v[104:105], v[12:15]
    v_mfma_f32_16x16x16_bf16 v[16:19], v[88:89], v[106:107], v[16:19]
    s_waitcnt vmcnt(6)
    v_mfma_f32_16x16x16_bf16 v[12:15], v[90:91], v[108:109], v[12:15]
    v_mfma_f32_16x16x16_bf16 v[16:19], v[90:91], v[110:111], v[16:19]
    s_waitcnt vmcnt(5)
    v_mfma_f32_16x16x16_bf16 v[12:15], v[92:93], v[112:113], v[12:15]
    v_mfma_f32_16x16x16_bf16 v[16:19], v[92:93], v[114:115], v[16:19]
    s_waitcnt vmcnt(4)
    v_mfma_f32_16x16x16_bf16 v[12:15], v[94:95], v[116:117], v[12:15]
    v_mfma_f32_16x16x16_bf16 v[16:19], v[94:95], v[118:119], v[16:19]
    s_waitcnt vmcnt(3)
    v_mfma_f32_16x16x16_bf16 v[12:15], v[96:97], v[120:121], v[12:15]
    v_mfma_f32_16x16x16_bf16 v[16:19], v[96:97], v[122:123], v[16:19]
    s_waitcnt vmcnt(2)
    v_mfma_f32_16x16x16_bf16 v[12:15], v[98:99], v[124:125], v[12:15]
    v_mfma_f32_16x16x16_bf16 v[16:19], v[98:99], v[126:127], v[16:19]
    s_waitcnt vmcnt(1)
    v_mfma_f32_16x16x16_bf16 v[12:15], v[100:101], v[128:129], v[12:15]
    v_mfma_f32_16x16x16_bf16 v[16:19], v[100:101], v[130:131], v[16:19]
    s_waitcnt vmcnt(0)
    v_mfma_f32_16x16x16_bf16 v[12:15], v[102:103], v[132:133], v[12:15]
    v_mfma_f32_16x16x16_bf16 v[16:19], v[102:103], v[134:135], v[16:19]
    s_nop 6
    ds_write_b128 v36, v[12:15] offset:128
    ds_write_b128 v36, v[16:19] offset:1152
    s_waitcnt lgkmcnt(0)
    s_barrier
    ds_read2st64_b32 v[56:57], v43 offset0:0 offset1:4
    ds_read2st64_b32 v[58:59], v43 offset0:8 offset1:12
    ds_read2st64_b32 v[60:61], v43 offset0:16 offset1:20
    ds_read2st64_b32 v[62:63], v43 offset0:24 offset1:28
    s_waitcnt lgkmcnt(0)
    v_mul_f32 v44, v20, v56
    v_mul_f32 v45, v20, v57
    v_fmac_f32 v44, v22, v58
    v_fmac_f32 v45, v22, v59
    v_fmac_f32 v44, v24, v60
    v_fmac_f32 v45, v24, v61
    v_fmac_f32 v44, v26, v62
    v_fmac_f32 v45, v26, v63
    buffer_store_dwordx4 v[44:47], v42, s[60:63], s58 offen sc1
    s_cmp_lg_u32 s48, 0
    s_cbranch_scc1 L_end
L_poll:
    buffer_load_dwordx4 v[104:107], v1, s[60:63], s59 offen offset:0 sc1
    buffer_load_dwordx4 v[108:111], v1, s[60:63], s59 offen offset:1024 sc1
    buffer_load_dwordx4 v[112:115], v1, s[60:63], s59 offen offset:2048 sc1
    buffer_load_dwordx4 v[116:119], v1, s[60:63], s59 offen offset:3072 sc1
    s_waitcnt vmcnt(0)
    v_cmp_eq_u32 vcc, v107, v2
    v_cmp_eq_u32 s[68:69], v111, v2
    s_and_b64 vcc, vcc, s[68:69]
    v_cmp_eq_u32 s[68:69], v115, v2
    s_and_b64 vcc, vcc, s[68:69]
    v_cmp_eq_u32 s[68:69], v119, v2
    s_and_b64 vcc, vcc, s[68:69]
    s_cmp_eq_u64 vcc, -1
    s_cbranch_scc1 L_ready0
    s_sleep 1
    s_sub_u32 s64, s64, 1
    s_cmp_lg_u32 s64, 0
    s_cbranch_scc1 L_poll
L_ready0:
    v_max3_f32 v20, v106, v110, v114
    v_max_f32 v20, v20, v118
    v_mov_b32 v21, v20
    s_nop 1
    v_permlane32_swap_b32 v20, v21
    v_max_f32 v20, v20, v21
    v_mov_b32 v21, v20
    s_nop 1
    v_permlane16_swap_b32 v20, v21
    v_max_f32 v20, v20, v21
    v_sub_f32 v106, v106, v20
    v_sub_f32 v110, v110, v20
    v_sub_f32 v114, v114, v20
    v_sub_f32 v118, v118, v20
    v_exp_f32 v106, v106
    v_exp_f32 v110, v110
    v_exp_f32 v114, v114
    v_exp_f32 v118, v118
    v_add_f32 v22, v106, v110
    v_mul_f32 v24, v106, v104
    v_mul_f32 v25, v106, v105
    v_add_f32 v23, v114, v118
    v_fmac_f32 v24, v110, v108
    v_fmac_f32 v25, v110, v109
    v_add_f32 v22, v22, v23
    v_fmac_f32 v24, v114, v112
    v_fmac_f32 v25, v114, v113
    v_fmac_f32 v24, v118, v116
    v_fmac_f32 v25, v118, v117
    v_mov_b32 v23, v22
    s_nop 0
    v_permlane32_swap_b32 v24, v25
    v_permlane32_swap_b32 v22, v23
    v_add_f32 v24, v24, v25
    v_add_f32 v22, v22, v23
    s_nop 1
    v_permlane16_swap_b32 v24, v22
    v_add_f32 v24, v24, v22
    v_mov_b32 v22, v24
    s_nop 1
    v_permlane16_swap_b32 v24, v22
    v_rcp_f32 v22, v22
    s_nop 0
    v_mul_f32 v24, v24, v22
    v_cvt_pk_bf16_f32 v24, v24, v24
    s_mov_b32 exec_lo, 0xffff
    s_mov_b32 exec_hi, 0xffff
    buffer_store_short v24, v37, s[44:47], s66 offen sc1
    s_add_u32 s55, s55, 1
    s_mov_b64 exec, 1
    v_mov_b32 v3, s55
    v_mov_b32 v2, 0
    buffer_store_dword v3, v2, s[60:63], s53 offen sc1
    s_endpgm
L_tree:
    s_waitcnt lgkmcnt(0)
    v_mfma_f32_16x16x32_bf16 v[100:103], v[12:15], v[8:11], 0
    s_lshl_b32 s51, s52, 16
    s_and_b32 s52, s52, 0xffff0000
    s_cmp_ge_u32 s2, 128
    s_cselect_b32 s52, s52, s51
    v_mov_b32 v37, s52
    v_sub_f32 v37, 1.0, v37
    v_mul_f32 v37, 0xd028965f, v37
    v_lshlrev_b32 v16, 16, v16
    v_lshlrev_b32 v17, 16, v17
    v_mov_b32_dpp v100, v101 quad_perm:[0,1,2,3] row_mask:0xf bank_mask:0x2
    v_mov_b32_dpp v100, v102 quad_perm:[0,1,2,3] row_mask:0xf bank_mask:0x4
    v_mov_b32_dpp v100, v103 quad_perm:[0,1,2,3] row_mask:0xf bank_mask:0x8
    s_nop 1
    v_add_f32_dpp v101, v100, v100 row_ror:8 row_mask:0xf bank_mask:0xf
    s_nop 1
    v_add_f32_dpp v102, v101, v101 row_ror:4 row_mask:0xf bank_mask:0xf
    v_add_f32 v3, v102, v37
    v_max_f32 v36, v36, v3
    s_branch L_tree_ret
L_tree_acc:
    v_fma_f32 v37, v3, s49, -v6
    v_exp_f32 v37, v37
    v_cmp_gt_u32 vcc, 16, v0
    v_mov_b32 v20, v16
    v_mov_b32 v21, v17
    v_cndmask_b32 v7, 0, v37, vcc
    v_mul_f32_dpp v12, v37, v20 quad_perm:[0,0,0,0] row_mask:0xf bank_mask:0xf
    v_mul_f32_dpp v16, v37, v21 quad_perm:[0,0,0,0] row_mask:0xf bank_mask:0xf
    v_mul_f32_dpp v13, v37, v20 quad_perm:[1,1,1,1] row_mask:0xf bank_mask:0xf
    v_mul_f32_dpp v17, v37, v21 quad_perm:[1,1,1,1] row_mask:0xf bank_mask:0xf
    v_mul_f32_dpp v14, v37, v20 quad_perm:[2,2,2,2] row_mask:0xf bank_mask:0xf
    v_mul_f32_dpp v18, v37, v21 quad_perm:[2,2,2,2] row_mask:0xf bank_mask:0xf
    v_mul_f32_dpp v15, v37, v20 quad_perm:[3,3,3,3] row_mask:0xf bank_mask:0xf
    v_mul_f32_dpp v19, v37, v21 quad_perm:[3,3,3,3] row_mask:0xf bank_mask:0xf
    s_nop 1
    s_branch L_tree_acc_done
L_end:
    s_endpgm
L_code_end:
.section .rodata,"a"
.p2align 6
.amdhsa_kernel standalone__tree_speculative_verify_tree_attention_over_candidate_token_tree__decode_kernel
  .amdhsa_next_free_vgpr 152
  .amdhsa_next_free_sgpr 102
  .amdhsa_accum_offset 152
  .amdhsa_group_segment_fixed_size 0
  .amdhsa_kernarg_size 72
  .amdhsa_user_sgpr_count 2
  .amdhsa_user_sgpr_kernarg_segment_ptr 1
  .amdhsa_system_sgpr_workgroup_id_x 1
.end_amdhsa_kernel
```
